```python
import torch

def _softmax(x, axis=-1):
    return torch.softmax(x, dim=axis)

def _gelu(x):
    return torch.nn.functional.gelu(x, approximate='tanh')

def _silu(x):
    return torch.nn.functional.silu(x)

def _sigmoid(x):
    return torch.sigmoid(x)

def _layernorm(x, axis=-1, eps=1e-05):
    m = x.mean(dim=axis, keepdim=True)
    v = x.var(dim=axis, keepdim=True, unbiased=False)
    return (x - m) / torch.sqrt(v + eps)

def _scatter_add(tgt, idx, src, axis=0):
    return tgt.clone().index_add_(axis, idx, src)

def _segment_sum(src, seg, n):
    out = torch.zeros((n,) + src.shape[1:], dtype=src.dtype)
    return out.index_add_(0, seg, src)

def _pad(x, pw):
    flat = tuple((v for pair in reversed(pw) for v in pair))
    return torch.nn.functional.pad(x, flat)
kernel_name = 'standalone__tree_speculative_verify_tree_attention_over_candidate_token_tree__decode'

def setup_inputs():

    _w = lambda a: (lambda t: t.to(torch.bfloat16) if t.is_floating_point() else t)(torch.as_tensor(a))
    B, Hq, Hkv, T, C, D = (2, 32, 8, 1, 32768, 128)
    tree_mask = torch.zeros((B, T, T), dtype=float)
    for b in range(B):
        parent = torch.zeros(T, dtype=torch.int64)
        for i in range(1, T):
            parent[i] = int(torch.randint(0, i, (1,)).item())
        for i in range(T):
            j = i
            tree_mask[b, i, j] = 1.0
            while j > 0:
                j = parent[j]
                tree_mask[b, i, j] = 1.0
    return {'q': _w((lambda *s: torch.randn(*s, dtype=torch.bfloat16) * 0.8)(B, Hq, T, D)), 'k_cache': _w((lambda *s: torch.randn(*s, dtype=torch.bfloat16) * 0.8)(B, Hkv, C, D)), 'v_cache': _w((lambda *s: torch.randn(*s, dtype=torch.bfloat16) * 0.05)(B, Hkv, C, D)), 'k_tree': _w((lambda *s: torch.randn(*s, dtype=torch.bfloat16) * 0.8)(B, Hkv, T, D)), 'v_tree': _w((lambda *s: torch.randn(*s, dtype=torch.bfloat16) * 0.05)(B, Hkv, T, D)), 'tree_mask': _w(tree_mask)}

def reference(q, k_cache, v_cache, k_tree, v_tree, tree_mask):
    B, Hq, T, D = q.shape
    Hkv, C = (k_cache.shape[1], k_cache.shape[2])
    rep = Hq // Hkv
    kc = (lambda x, n, axis: torch.repeat_interleave(x, n, dim=axis))(k_cache, rep, axis=1)
    vc = (lambda x, n, axis: torch.repeat_interleave(x, n, dim=axis))(v_cache, rep, axis=1)
    kt = (lambda x, n, axis: torch.repeat_interleave(x, n, dim=axis))(k_tree, rep, axis=1)
    vt = (lambda x, n, axis: torch.repeat_interleave(x, n, dim=axis))(v_tree, rep, axis=1)
    k = torch.concatenate([kc, kt], axis=2)
    v = torch.concatenate([vc, vt], axis=2)
    scale = D ** (-0.5)
    scores = torch.einsum('bhqd,bhkd->bhqk', q, k) * scale
    ctx_mask = torch.ones((B, 1, T, C), dtype=scores.dtype)
    tm = tree_mask[:, None, :, :].clone()
    full_mask = torch.concatenate([ctx_mask, tm], axis=-1)
    scores = scores + (1.0 - full_mask) * -1000000000.0
    p = _softmax(scores, axis=-1)
    return torch.einsum('bhqk,bhkd->bhqd', p, v)
```

```asm
; @launch grid=(256,1,1) block=(384,1,1) lds=74832
.amdgcn_target "amdgcn-amd-amdhsa--gfx950"
.text
.globl standalone__tree_speculative_verify_tree_attention_over_candidate_token_tree__decode_kernel
.p2align 8
.type standalone__tree_speculative_verify_tree_attention_over_candidate_token_tree__decode_kernel,@function
standalone__tree_speculative_verify_tree_attention_over_candidate_token_tree__decode_kernel:
    s_load_dwordx2 s[24:25], s[0:1], 8
    v_readfirstlane_b32 s3, v0
    s_cmp_ge_u32 s2, 256
    s_cbranch_scc1 L_end
    s_and_b32 s6, s2, 15
    s_lshr_b32 s7, s2, 4
    s_cmp_eq_u32 s3, 0
    s_cbranch_scc1 L_loader
    s_load_dwordx2 s[28:29], s[0:1], 16
    s_load_dwordx8 s[12:19], s[0:1], 40
    s_sub_u32 s32, s3, 64
    s_or_b32 s32, s32, s7
    s_cbranch_scc1 L_nopre
    s_getpc_b64 s[36:37]
L_pc:
    v_lshlrev_b32 v1, 7, v0
    v_and_b32 v1, 0x1fff, v1
    v_min_u32 v1, L_last-L_pc, v1
    global_load_dword v38, v1, s[36:37]
L_nopre:
    s_cmp_eq_u32 s3, 320
    s_cbranch_scc1 L_ctrl
    s_branch L_cons
L_loader:
    s_setprio 3
    s_lshl_b32 s38, s6, 23
    s_bfe_u32 s32, s7, 0x30000
    s_lshl_b32 s32, s32, 14
    s_xor_b32 s38, s38, s32
    s_bfe_u32 s32, s7, 0x10003
    s_lshl_b32 s32, s32, 18
    s_xor_b32 s38, s38, s32
    s_bfe_u32 s32, s7, 0x20001
    s_lshl_b32 s32, s32, 12
    s_xor_b32 s38, s38, s32
    s_mov_b32 s20, s38
    s_mov_b32 s26, 0x8000000
    s_mov_b32 s27, 0x00020000
    s_mov_b32 m0, 0
    v_lshlrev_b32 v3, 4, v0
    v_and_b32 v4, 32, v0
    v_lshlrev_b32 v4, 2, v4
    v_xor_b32 v1, v3, v4
    s_waitcnt lgkmcnt(0)
    buffer_load_dwordx4 v1, s[24:27], s20 offen offset:0 nt lds
    buffer_load_dwordx4 v1, s[24:27], s20 offen offset:1024 nt lds
    buffer_load_dwordx4 v1, s[24:27], s20 offen offset:2048 nt lds
    buffer_load_dwordx4 v1, s[24:27], s20 offen offset:3072 nt lds
    s_add_u32 m0, m0, 4096
    s_xor_b32 s20, s38, 4096
    buffer_load_dwordx4 v1, s[24:27], s20 offen offset:0 nt lds
    buffer_load_dwordx4 v1, s[24:27], s20 offen offset:1024 nt lds
    buffer_load_dwordx4 v1, s[24:27], s20 offen offset:2048 nt lds
    buffer_load_dwordx4 v1, s[24:27], s20 offen offset:3072 nt lds
    s_add_u32 m0, m0, 4096
    s_xor_b32 s20, s38, 8192
    buffer_load_dwordx4 v1, s[24:27], s20 offen offset:0 nt lds
    buffer_load_dwordx4 v1, s[24:27], s20 offen offset:1024 nt lds
    buffer_load_dwordx4 v1, s[24:27], s20 offen offset:2048 nt lds
    buffer_load_dwordx4 v1, s[24:27], s20 offen offset:3072 nt lds
    s_add_u32 m0, m0, 4096
    s_xor_b32 s20, s38, 12288
    buffer_load_dwordx4 v1, s[24:27], s20 offen offset:0 nt lds
    buffer_load_dwordx4 v1, s[24:27], s20 offen offset:1024 nt lds
    buffer_load_dwordx4 v1, s[24:27], s20 offen offset:2048 nt lds
    buffer_load_dwordx4 v1, s[24:27], s20 offen offset:3072 nt lds
    s_add_u32 m0, m0, 4096
    s_xor_b32 s38, s38, 2097152
    s_mov_b32 s20, s38
    buffer_load_dwordx4 v1, s[24:27], s20 offen offset:0 nt lds
    buffer_load_dwordx4 v1, s[24:27], s20 offen offset:1024 nt lds
    buffer_load_dwordx4 v1, s[24:27], s20 offen offset:2048 nt lds
    buffer_load_dwordx4 v1, s[24:27], s20 offen offset:3072 nt lds
    s_add_u32 m0, m0, 4096
    s_xor_b32 s20, s38, 4096
    s_load_dwordx2 s[28:29], s[0:1], 16
    s_load_dwordx8 s[12:19], s[0:1], 40
    s_xor_b32 s32, s38, 2097152
    v_mov_b32 v2, s32
    v_bfe_u32 v3, v0, 0, 1
    v_lshlrev_b32 v3, 21, v3
    v_xor_b32 v2, v2, v3
    v_bfe_u32 v3, v0, 1, 2
    v_lshlrev_b32 v3, 19, v3
    v_xor_b32 v2, v2, v3
    v_bfe_u32 v3, v0, 3, 1
    v_lshlrev_b32 v3, 22, v3
    v_xor_b32 v2, v2, v3
    v_bfe_u32 v3, v0, 4, 1
    v_lshlrev_b32 v3, 17, v3
    v_xor_b32 v2, v2, v3
    s_lshl_b32 s34, s6, 4
    s_add_u32 s34, s34, s7
    v_mov_b32 v5, 74816
    v_mov_b32 v6, 4
    v_lshrrev_b32 v3, 4, v0
    v_and_b32 v4, 15, v0
    v_and_b32 v7, 1, v0
    v_mul_u32_u24 v7, 24, v7
    v_bfe_u32 v8, v0, 1, 3
    v_add_u32 v7, v7, v8
    v_lshl_add_u32 v7, v3, 5, v7
    v_lshlrev_b32 v7, 4, v7
    v_add_u32 v7, 65536, v7
    v_xor_b32 v8, 0x80, v7
    s_lshl_b32 s32, s34, 11
    v_lshl_add_u32 v9, v3, 5, v4
    v_lshl_add_u32 v9, v9, 4, s32
    s_mov_b32 s37, 2
    s_waitcnt vmcnt(19)
    buffer_load_dwordx4 v1, s[24:27], s20 offen offset:0 nt lds
    s_waitcnt vmcnt(19)
    buffer_load_dwordx4 v1, s[24:27], s20 offen offset:1024 nt lds
    s_waitcnt vmcnt(19)
    buffer_load_dwordx4 v1, s[24:27], s20 offen offset:2048 nt lds
    s_waitcnt vmcnt(19)
    buffer_load_dwordx4 v1, s[24:27], s20 offen offset:3072 nt lds
    s_add_u32 m0, m0, 4096
    s_xor_b32 s20, s38, 8192
    s_waitcnt vmcnt(19)
    buffer_load_dwordx4 v1, s[24:27], s20 offen offset:0 nt lds
    s_waitcnt vmcnt(19)
    buffer_load_dwordx4 v1, s[24:27], s20 offen offset:1024 nt lds
    s_waitcnt vmcnt(19)
    buffer_load_dwordx4 v1, s[24:27], s20 offen offset:2048 nt lds
    s_waitcnt vmcnt(19)
    buffer_load_dwordx4 v1, s[24:27], s20 offen offset:3072 nt lds
    s_add_u32 m0, m0, 4096
    s_xor_b32 s20, s38, 12288
    s_waitcnt vmcnt(19)
    buffer_load_dwordx4 v1, s[24:27], s20 offen offset:0 nt lds
    s_waitcnt vmcnt(19)
    buffer_load_dwordx4 v1, s[24:27], s20 offen offset:1024 nt lds
    s_waitcnt vmcnt(19)
    buffer_load_dwordx4 v1, s[24:27], s20 offen offset:2048 nt lds
    s_waitcnt vmcnt(19)
    buffer_load_dwordx4 v1, s[24:27], s20 offen offset:3072 nt lds
    s_add_u32 m0, m0, 4096
L_next:
    v_readlane_b32 s38, v2, s37
    s_waitcnt lgkmcnt(0)
    v_readfirstlane_b32 s5, v6
    s_and_b32 m0, m0, 65535
    s_cmp_eq_u32 s37, 32
    s_cselect_b64 s[24:25], s[28:29], s[24:25]
    s_add_u32 s37, s37, 1
    s_mov_b32 s20, s38
    s_bitcmp1_b32 s5, 2
    s_cbranch_scc1 L_lv4
    s_bitcmp1_b32 s5, 1
    s_cbranch_scc1 L_lv2
    s_bitcmp1_b32 s5, 0
    s_cbranch_scc1 L_lv1
    s_waitcnt vmcnt(22)
    buffer_load_dwordx4 v1, s[24:27], s20 offen offset:0 nt lds
    s_waitcnt vmcnt(22)
    buffer_load_dwordx4 v1, s[24:27], s20 offen offset:1024 nt lds
    s_waitcnt vmcnt(22)
    buffer_load_dwordx4 v1, s[24:27], s20 offen offset:2048 nt lds
    s_waitcnt vmcnt(22)
    buffer_load_dwordx4 v1, s[24:27], s20 offen offset:3072 nt lds
    s_add_u32 m0, m0, 4096
    s_xor_b32 s20, s38, 4096
    s_waitcnt vmcnt(22)
    buffer_load_dwordx4 v1, s[24:27], s20 offen offset:0 nt lds
    s_waitcnt vmcnt(22)
    buffer_load_dwordx4 v1, s[24:27], s20 offen offset:1024 nt lds
    s_waitcnt vmcnt(22)
    buffer_load_dwordx4 v1, s[24:27], s20 offen offset:2048 nt lds
    s_barrier
    s_waitcnt vmcnt(22)
    buffer_load_dwordx4 v1, s[24:27], s20 offen offset:3072 nt lds
    s_add_u32 m0, m0, 4096
    s_xor_b32 s20, s38, 8192
    s_waitcnt vmcnt(22)
    buffer_load_dwordx4 v1, s[24:27], s20 offen offset:0 nt lds
    s_waitcnt vmcnt(22)
    buffer_load_dwordx4 v1, s[24:27], s20 offen offset:1024 nt lds
    s_waitcnt vmcnt(22)
    buffer_load_dwordx4 v1, s[24:27], s20 offen offset:2048 nt lds
    s_waitcnt vmcnt(22)
    buffer_load_dwordx4 v1, s[24:27], s20 offen offset:3072 nt lds
    s_add_u32 m0, m0, 4096
    s_xor_b32 s20, s38, 12288
    s_waitcnt vmcnt(22)
    buffer_load_dwordx4 v1, s[24:27], s20 offen offset:0 nt lds
    s_waitcnt vmcnt(22)
    buffer_load_dwordx4 v1, s[24:27], s20 offen offset:1024 nt lds
    s_waitcnt vmcnt(22)
    buffer_load_dwordx4 v1, s[24:27], s20 offen offset:2048 nt lds
    ds_read_b32 v6, v5
    s_waitcnt vmcnt(22)
    buffer_load_dwordx4 v1, s[24:27], s20 offen offset:3072 nt lds
    s_add_u32 m0, m0, 4096
    s_cmp_lt_u32 s37, 64
    s_cbranch_scc1 L_next
    s_branch L_drain
L_lv1:
    s_waitcnt vmcnt(21)
    buffer_load_dwordx4 v1, s[24:27], s20 offen offset:0 nt lds
    s_waitcnt vmcnt(21)
    buffer_load_dwordx4 v1, s[24:27], s20 offen offset:1024 nt lds
    s_waitcnt vmcnt(21)
    buffer_load_dwordx4 v1, s[24:27], s20 offen offset:2048 nt lds
    s_waitcnt vmcnt(21)
    buffer_load_dwordx4 v1, s[24:27], s20 offen offset:3072 nt lds
    s_add_u32 m0, m0, 4096
    s_xor_b32 s20, s38, 4096
    s_waitcnt vmcnt(21)
    buffer_load_dwordx4 v1, s[24:27], s20 offen offset:0 nt lds
    s_waitcnt vmcnt(21)
    buffer_load_dwordx4 v1, s[24:27], s20 offen offset:1024 nt lds
    s_waitcnt vmcnt(21)
    buffer_load_dwordx4 v1, s[24:27], s20 offen offset:2048 nt lds
    s_barrier
    s_waitcnt vmcnt(21)
    buffer_load_dwordx4 v1, s[24:27], s20 offen offset:3072 nt lds
    s_add_u32 m0, m0, 4096
    s_xor_b32 s20, s38, 8192
    s_waitcnt vmcnt(21)
    buffer_load_dwordx4 v1, s[24:27], s20 offen offset:0 nt lds
    s_waitcnt vmcnt(21)
    buffer_load_dwordx4 v1, s[24:27], s20 offen offset:1024 nt lds
    s_waitcnt vmcnt(21)
    buffer_load_dwordx4 v1, s[24:27], s20 offen offset:2048 nt lds
    s_waitcnt vmcnt(21)
    buffer_load_dwordx4 v1, s[24:27], s20 offen offset:3072 nt lds
    s_add_u32 m0, m0, 4096
    s_xor_b32 s20, s38, 12288
    s_waitcnt vmcnt(21)
    buffer_load_dwordx4 v1, s[24:27], s20 offen offset:0 nt lds
    s_waitcnt vmcnt(21)
    buffer_load_dwordx4 v1, s[24:27], s20 offen offset:1024 nt lds
    s_waitcnt vmcnt(21)
    buffer_load_dwordx4 v1, s[24:27], s20 offen offset:2048 nt lds
    ds_read_b32 v6, v5
    s_waitcnt vmcnt(21)
    buffer_load_dwordx4 v1, s[24:27], s20 offen offset:3072 nt lds
    s_add_u32 m0, m0, 4096
    s_cmp_lt_u32 s37, 64
    s_cbranch_scc1 L_next
    s_branch L_drain
L_lv2:
    s_bitcmp1_b32 s5, 0
    s_cbranch_scc1 L_lv3
    s_waitcnt vmcnt(20)
    buffer_load_dwordx4 v1, s[24:27], s20 offen offset:0 nt lds
    s_waitcnt vmcnt(20)
    buffer_load_dwordx4 v1, s[24:27], s20 offen offset:1024 nt lds
    s_waitcnt vmcnt(20)
    buffer_load_dwordx4 v1, s[24:27], s20 offen offset:2048 nt lds
    s_waitcnt vmcnt(20)
    buffer_load_dwordx4 v1, s[24:27], s20 offen offset:3072 nt lds
    s_add_u32 m0, m0, 4096
    s_xor_b32 s20, s38, 4096
    s_waitcnt vmcnt(20)
    buffer_load_dwordx4 v1, s[24:27], s20 offen offset:0 nt lds
    s_waitcnt vmcnt(20)
    buffer_load_dwordx4 v1, s[24:27], s20 offen offset:1024 nt lds
    s_waitcnt vmcnt(20)
    buffer_load_dwordx4 v1, s[24:27], s20 offen offset:2048 nt lds
    s_barrier
    s_waitcnt vmcnt(20)
    buffer_load_dwordx4 v1, s[24:27], s20 offen offset:3072 nt lds
    s_add_u32 m0, m0, 4096
    s_xor_b32 s20, s38, 8192
    s_waitcnt vmcnt(20)
    buffer_load_dwordx4 v1, s[24:27], s20 offen offset:0 nt lds
    s_waitcnt vmcnt(20)
    buffer_load_dwordx4 v1, s[24:27], s20 offen offset:1024 nt lds
    s_waitcnt vmcnt(20)
    buffer_load_dwordx4 v1, s[24:27], s20 offen offset:2048 nt lds
    s_waitcnt vmcnt(20)
    buffer_load_dwordx4 v1, s[24:27], s20 offen offset:3072 nt lds
    s_add_u32 m0, m0, 4096
    s_xor_b32 s20, s38, 12288
    s_waitcnt vmcnt(20)
    buffer_load_dwordx4 v1, s[24:27], s20 offen offset:0 nt lds
    s_waitcnt vmcnt(20)
    buffer_load_dwordx4 v1, s[24:27], s20 offen offset:1024 nt lds
    s_waitcnt vmcnt(20)
    buffer_load_dwordx4 v1, s[24:27], s20 offen offset:2048 nt lds
    ds_read_b32 v6, v5
    s_waitcnt vmcnt(20)
    buffer_load_dwordx4 v1, s[24:27], s20 offen offset:3072 nt lds
    s_add_u32 m0, m0, 4096
    s_cmp_lt_u32 s37, 64
    s_cbranch_scc1 L_next
    s_branch L_drain
L_lv3:
    s_waitcnt vmcnt(19)
    buffer_load_dwordx4 v1, s[24:27], s20 offen offset:0 nt lds
    s_waitcnt vmcnt(19)
    buffer_load_dwordx4 v1, s[24:27], s20 offen offset:1024 nt lds
    s_waitcnt vmcnt(19)
    buffer_load_dwordx4 v1, s[24:27], s20 offen offset:2048 nt lds
    s_waitcnt vmcnt(19)
    buffer_load_dwordx4 v1, s[24:27], s20 offen offset:3072 nt lds
    s_add_u32 m0, m0, 4096
    s_xor_b32 s20, s38, 4096
    s_waitcnt vmcnt(19)
    buffer_load_dwordx4 v1, s[24:27], s20 offen offset:0 nt lds
    s_waitcnt vmcnt(19)
    buffer_load_dwordx4 v1, s[24:27], s20 offen offset:1024 nt lds
    s_waitcnt vmcnt(19)
    buffer_load_dwordx4 v1, s[24:27], s20 offen offset:2048 nt lds
    s_barrier
    s_waitcnt vmcnt(19)
    buffer_load_dwordx4 v1, s[24:27], s20 offen offset:3072 nt lds
    s_add_u32 m0, m0, 4096
    s_xor_b32 s20, s38, 8192
    s_waitcnt vmcnt(19)
    buffer_load_dwordx4 v1, s[24:27], s20 offen offset:0 nt lds
    s_waitcnt vmcnt(19)
    buffer_load_dwordx4 v1, s[24:27], s20 offen offset:1024 nt lds
    s_waitcnt vmcnt(19)
    buffer_load_dwordx4 v1, s[24:27], s20 offen offset:2048 nt lds
    s_waitcnt vmcnt(19)
    buffer_load_dwordx4 v1, s[24:27], s20 offen offset:3072 nt lds
    s_add_u32 m0, m0, 4096
    s_xor_b32 s20, s38, 12288
    s_waitcnt vmcnt(19)
    buffer_load_dwordx4 v1, s[24:27], s20 offen offset:0 nt lds
    s_waitcnt vmcnt(19)
    buffer_load_dwordx4 v1, s[24:27], s20 offen offset:1024 nt lds
    s_waitcnt vmcnt(19)
    buffer_load_dwordx4 v1, s[24:27], s20 offen offset:2048 nt lds
    ds_read_b32 v6, v5
    s_waitcnt vmcnt(19)
    buffer_load_dwordx4 v1, s[24:27], s20 offen offset:3072 nt lds
    s_add_u32 m0, m0, 4096
    s_cmp_lt_u32 s37, 64
    s_cbranch_scc1 L_next
    s_branch L_drain
L_lv4:
    s_bitcmp1_b32 s5, 1
    s_cbranch_scc1 L_lv6
    s_bitcmp1_b32 s5, 0
    s_cbranch_scc1 L_lv5
    s_waitcnt vmcnt(18)
    buffer_load_dwordx4 v1, s[24:27], s20 offen offset:0 nt lds
    s_waitcnt vmcnt(18)
    buffer_load_dwordx4 v1, s[24:27], s20 offen offset:1024 nt lds
    s_waitcnt vmcnt(18)
    buffer_load_dwordx4 v1, s[24:27], s20 offen offset:2048 nt lds
    s_waitcnt vmcnt(18)
    buffer_load_dwordx4 v1, s[24:27], s20 offen offset:3072 nt lds
    s_add_u32 m0, m0, 4096
    s_xor_b32 s20, s38, 4096
    s_waitcnt vmcnt(18)
    buffer_load_dwordx4 v1, s[24:27], s20 offen offset:0 nt lds
    s_waitcnt vmcnt(18)
    buffer_load_dwordx4 v1, s[24:27], s20 offen offset:1024 nt lds
    s_waitcnt vmcnt(18)
    buffer_load_dwordx4 v1, s[24:27], s20 offen offset:2048 nt lds
    s_barrier
    s_waitcnt vmcnt(18)
    buffer_load_dwordx4 v1, s[24:27], s20 offen offset:3072 nt lds
    s_add_u32 m0, m0, 4096
    s_xor_b32 s20, s38, 8192
    s_waitcnt vmcnt(18)
    buffer_load_dwordx4 v1, s[24:27], s20 offen offset:0 nt lds
    s_waitcnt vmcnt(18)
    buffer_load_dwordx4 v1, s[24:27], s20 offen offset:1024 nt lds
    s_waitcnt vmcnt(18)
    buffer_load_dwordx4 v1, s[24:27], s20 offen offset:2048 nt lds
    s_waitcnt vmcnt(18)
    buffer_load_dwordx4 v1, s[24:27], s20 offen offset:3072 nt lds
    s_add_u32 m0, m0, 4096
    s_xor_b32 s20, s38, 12288
    s_waitcnt vmcnt(18)
    buffer_load_dwordx4 v1, s[24:27], s20 offen offset:0 nt lds
    s_waitcnt vmcnt(18)
    buffer_load_dwordx4 v1, s[24:27], s20 offen offset:1024 nt lds
    s_waitcnt vmcnt(18)
    buffer_load_dwordx4 v1, s[24:27], s20 offen offset:2048 nt lds
    ds_read_b32 v6, v5
    s_waitcnt vmcnt(18)
    buffer_load_dwordx4 v1, s[24:27], s20 offen offset:3072 nt lds
    s_add_u32 m0, m0, 4096
    s_cmp_lt_u32 s37, 64
    s_cbranch_scc1 L_next
    s_branch L_drain
L_lv5:
    s_waitcnt vmcnt(17)
    buffer_load_dwordx4 v1, s[24:27], s20 offen offset:0 nt lds
    s_waitcnt vmcnt(17)
    buffer_load_dwordx4 v1, s[24:27], s20 offen offset:1024 nt lds
    s_waitcnt vmcnt(17)
    buffer_load_dwordx4 v1, s[24:27], s20 offen offset:2048 nt lds
    s_waitcnt vmcnt(17)
    buffer_load_dwordx4 v1, s[24:27], s20 offen offset:3072 nt lds
    s_add_u32 m0, m0, 4096
    s_xor_b32 s20, s38, 4096
    s_waitcnt vmcnt(17)
    buffer_load_dwordx4 v1, s[24:27], s20 offen offset:0 nt lds
    s_waitcnt vmcnt(17)
    buffer_load_dwordx4 v1, s[24:27], s20 offen offset:1024 nt lds
    s_waitcnt vmcnt(17)
    buffer_load_dwordx4 v1, s[24:27], s20 offen offset:2048 nt lds
    s_barrier
    s_waitcnt vmcnt(17)
    buffer_load_dwordx4 v1, s[24:27], s20 offen offset:3072 nt lds
    s_add_u32 m0, m0, 4096
    s_xor_b32 s20, s38, 8192
    s_waitcnt vmcnt(17)
    buffer_load_dwordx4 v1, s[24:27], s20 offen offset:0 nt lds
    s_waitcnt vmcnt(17)
    buffer_load_dwordx4 v1, s[24:27], s20 offen offset:1024 nt lds
    s_waitcnt vmcnt(17)
    buffer_load_dwordx4 v1, s[24:27], s20 offen offset:2048 nt lds
    s_waitcnt vmcnt(17)
    buffer_load_dwordx4 v1, s[24:27], s20 offen offset:3072 nt lds
    s_add_u32 m0, m0, 4096
    s_xor_b32 s20, s38, 12288
    s_waitcnt vmcnt(17)
    buffer_load_dwordx4 v1, s[24:27], s20 offen offset:0 nt lds
    s_waitcnt vmcnt(17)
    buffer_load_dwordx4 v1, s[24:27], s20 offen offset:1024 nt lds
    s_waitcnt vmcnt(17)
    buffer_load_dwordx4 v1, s[24:27], s20 offen offset:2048 nt lds
    ds_read_b32 v6, v5
    s_waitcnt vmcnt(17)
    buffer_load_dwordx4 v1, s[24:27], s20 offen offset:3072 nt lds
    s_add_u32 m0, m0, 4096
    s_cmp_lt_u32 s37, 64
    s_cbranch_scc1 L_next
    s_branch L_drain
L_lv6:
    s_bitcmp1_b32 s5, 0
    s_cbranch_scc1 L_lv7
    s_waitcnt vmcnt(16)
    buffer_load_dwordx4 v1, s[24:27], s20 offen offset:0 nt lds
    s_waitcnt vmcnt(16)
    buffer_load_dwordx4 v1, s[24:27], s20 offen offset:1024 nt lds
    s_waitcnt vmcnt(16)
    buffer_load_dwordx4 v1, s[24:27], s20 offen offset:2048 nt lds
    s_waitcnt vmcnt(16)
    buffer_load_dwordx4 v1, s[24:27], s20 offen offset:3072 nt lds
    s_add_u32 m0, m0, 4096
    s_xor_b32 s20, s38, 4096
    s_waitcnt vmcnt(16)
    buffer_load_dwordx4 v1, s[24:27], s20 offen offset:0 nt lds
    s_waitcnt vmcnt(16)
    buffer_load_dwordx4 v1, s[24:27], s20 offen offset:1024 nt lds
    s_waitcnt vmcnt(16)
    buffer_load_dwordx4 v1, s[24:27], s20 offen offset:2048 nt lds
    s_barrier
    s_waitcnt vmcnt(16)
    buffer_load_dwordx4 v1, s[24:27], s20 offen offset:3072 nt lds
    s_add_u32 m0, m0, 4096
    s_xor_b32 s20, s38, 8192
    s_waitcnt vmcnt(16)
    buffer_load_dwordx4 v1, s[24:27], s20 offen offset:0 nt lds
    s_waitcnt vmcnt(16)
    buffer_load_dwordx4 v1, s[24:27], s20 offen offset:1024 nt lds
    s_waitcnt vmcnt(16)
    buffer_load_dwordx4 v1, s[24:27], s20 offen offset:2048 nt lds
    s_waitcnt vmcnt(16)
    buffer_load_dwordx4 v1, s[24:27], s20 offen offset:3072 nt lds
    s_add_u32 m0, m0, 4096
    s_xor_b32 s20, s38, 12288
    s_waitcnt vmcnt(16)
    buffer_load_dwordx4 v1, s[24:27], s20 offen offset:0 nt lds
    s_waitcnt vmcnt(16)
    buffer_load_dwordx4 v1, s[24:27], s20 offen offset:1024 nt lds
    s_waitcnt vmcnt(16)
    buffer_load_dwordx4 v1, s[24:27], s20 offen offset:2048 nt lds
    ds_read_b32 v6, v5
    s_waitcnt vmcnt(16)
    buffer_load_dwordx4 v1, s[24:27], s20 offen offset:3072 nt lds
    s_add_u32 m0, m0, 4096
    s_cmp_lt_u32 s37, 64
    s_cbranch_scc1 L_next
    s_branch L_drain
L_lv7:
    s_waitcnt vmcnt(15)
    buffer_load_dwordx4 v1, s[24:27], s20 offen offset:0 nt lds
    s_waitcnt vmcnt(15)
    buffer_load_dwordx4 v1, s[24:27], s20 offen offset:1024 nt lds
    s_waitcnt vmcnt(15)
    buffer_load_dwordx4 v1, s[24:27], s20 offen offset:2048 nt lds
    s_waitcnt vmcnt(15)
    buffer_load_dwordx4 v1, s[24:27], s20 offen offset:3072 nt lds
    s_add_u32 m0, m0, 4096
    s_xor_b32 s20, s38, 4096
    s_waitcnt vmcnt(15)
    buffer_load_dwordx4 v1, s[24:27], s20 offen offset:0 nt lds
    s_waitcnt vmcnt(15)
    buffer_load_dwordx4 v1, s[24:27], s20 offen offset:1024 nt lds
    s_waitcnt vmcnt(15)
    buffer_load_dwordx4 v1, s[24:27], s20 offen offset:2048 nt lds
    s_barrier
    s_waitcnt vmcnt(15)
    buffer_load_dwordx4 v1, s[24:27], s20 offen offset:3072 nt lds
    s_add_u32 m0, m0, 4096
    s_xor_b32 s20, s38, 8192
    s_waitcnt vmcnt(15)
    buffer_load_dwordx4 v1, s[24:27], s20 offen offset:0 nt lds
    s_waitcnt vmcnt(15)
    buffer_load_dwordx4 v1, s[24:27], s20 offen offset:1024 nt lds
    s_waitcnt vmcnt(15)
    buffer_load_dwordx4 v1, s[24:27], s20 offen offset:2048 nt lds
    s_waitcnt vmcnt(15)
    buffer_load_dwordx4 v1, s[24:27], s20 offen offset:3072 nt lds
    s_add_u32 m0, m0, 4096
    s_xor_b32 s20, s38, 12288
    s_waitcnt vmcnt(15)
    buffer_load_dwordx4 v1, s[24:27], s20 offen offset:0 nt lds
    s_waitcnt vmcnt(15)
    buffer_load_dwordx4 v1, s[24:27], s20 offen offset:1024 nt lds
    s_waitcnt vmcnt(15)
    buffer_load_dwordx4 v1, s[24:27], s20 offen offset:2048 nt lds
    ds_read_b32 v6, v5
    s_waitcnt vmcnt(15)
    buffer_load_dwordx4 v1, s[24:27], s20 offen offset:3072 nt lds
    s_add_u32 m0, m0, 4096
    s_cmp_lt_u32 s37, 64
    s_cbranch_scc1 L_next
L_drain:
    s_waitcnt vmcnt(16)
    s_barrier
    s_waitcnt vmcnt(4)
    s_barrier
    ds_read_b32 v6, v5 offset:4
    s_waitcnt vmcnt(0)
    s_barrier
    s_waitcnt lgkmcnt(0)
    v_readfirstlane_b32 s5, v6
    s_nop 1
    s_cmp_lg_u32 s5, 0
    s_barrier
    ds_read_b128 v[20:23], v7 offset:0
    ds_read_b128 v[24:27], v7 offset:2048
    ds_read_b128 v[28:31], v7 offset:4096
    ds_read_b128 v[32:35], v7 offset:6144
    ds_read_b128 v[36:39], v8 offset:0
    ds_read_b128 v[40:43], v8 offset:2048
    ds_read_b128 v[44:47], v8 offset:4096
    ds_read_b128 v[48:51], v8 offset:6144
    s_waitcnt lgkmcnt(6)
    v_pk_add_f32 v[12:13], v[20:21], v[24:25]
    v_pk_add_f32 v[14:15], v[22:23], v[26:27]
    s_waitcnt lgkmcnt(5)
    v_pk_add_f32 v[12:13], v[12:13], v[28:29]
    v_pk_add_f32 v[14:15], v[14:15], v[30:31]
    s_waitcnt lgkmcnt(4)
    v_pk_add_f32 v[12:13], v[12:13], v[32:33]
    v_pk_add_f32 v[14:15], v[14:15], v[34:35]
    v_min_u32 v12, -2, v12
    v_min_u32 v13, -2, v13
    v_min_u32 v14, -2, v14
    v_min_u32 v15, -2, v15
    global_store_dwordx4 v9, v[12:15], s[18:19] offset:0
    s_waitcnt lgkmcnt(2)
    v_pk_add_f32 v[16:17], v[36:37], v[40:41]
    v_pk_add_f32 v[18:19], v[38:39], v[42:43]
    s_waitcnt lgkmcnt(1)
    v_pk_add_f32 v[16:17], v[16:17], v[44:45]
    v_pk_add_f32 v[18:19], v[18:19], v[46:47]
    s_waitcnt lgkmcnt(0)
    v_pk_add_f32 v[16:17], v[16:17], v[48:49]
    v_pk_add_f32 v[18:19], v[18:19], v[50:51]
    v_min_u32 v16, -2, v16
    v_min_u32 v17, -2, v17
    v_min_u32 v18, -2, v18
    v_min_u32 v19, -2, v19
    global_store_dwordx4 v9, v[16:19], s[18:19] offset:256
    s_cbranch_scc0 L_sent
    global_store_dwordx4 v9, v[12:15], s[18:19] offset:0 sc1
    global_store_dwordx4 v9, v[16:19], s[18:19] offset:256 sc1
L_sent:
    s_waitcnt vmcnt(0)
L_end:
    s_endpgm
L_ctrl:
    v_and_b32 v1, 63, v0
    s_lshl_b32 s34, s6, 4
    s_add_u32 s34, s34, s7
    v_and_b32 v5, 31, v1
    v_lshlrev_b32 v5, 2, v5
    s_lshl_b32 s32, s34, 11
    v_lshl_add_u32 v2, v1, 4, s32
    s_lshl_b32 s33, s34, 7
    s_add_u32 s33, s33, 1048576
    v_and_b32 v3, 7, v1
    v_lshl_add_u32 v3, v3, 4, s33
    v_mov_b32 v18, -1
    v_mov_b32 v19, -1
    v_mov_b32 v20, -1
    v_mov_b32 v21, -1
    v_mov_b32 v22, -1
    v_mov_b32 v23, -1
    v_mov_b32 v24, -1
    v_mov_b32 v25, -1
    v_mov_b32 v26, -1
    v_mov_b32 v27, -1
    s_waitcnt lgkmcnt(0)
    global_load_dword v6, v5, s[16:17] offset:128
    global_store_dwordx4 v2, v[20:23], s[18:19]
    global_store_dwordx4 v2, v[20:23], s[18:19] offset:1024
    global_store_dwordx4 v3, v[20:23], s[18:19]
    s_getreg_b32 s32, hwreg(HW_REG_XCC_ID, 0, 4)
    s_and_b32 s8, s32, 1
    s_mul_i32 s8, s8, 4
    s_add_u32 s8, s8, 11
    s_lshl_b32 s32, s32, 3
    s_and_b32 s4, s2, 7
    s_or_b32 s4, s4, s32
    s_lshr_b32 s32, s2, 3
    s_lshl_b32 s32, s32, 2
    v_mov_b32 v4, s32
    s_cmp_lt_u32 s2, 8
    s_cselect_b32 s10, 0x2040404, 0
    v_mov_b32 v8, 7
    v_mov_b32 v9, 64
    v_mov_b32 v10, 2
    v_mov_b32 v11, 74816
    v_mov_b32 v15, 4
    ds_write_b32 v11, v15
    s_mov_b32 s23, 0x3e0293ee
    s_lshl_b32 s32, s6, 2
    v_mov_b32 v39, s32
    v_lshrrev_b32 v14, 4, v1
    v_and_b32 v12, 15, v1
    v_lshlrev_b32 v12, 6, v12
    v_lshl_add_u32 v12, v14, 2, v12
    v_add_u32 v12, 73728, v12
    v_lshlrev_b32 v13, 4, v14
    v_add_u32 v13, 74752, v13
    v_lshl_add_u32 v36, v14, 3, s33
    v_lshrrev_b32 v38, 2, v1
    v_and_b32 v15, 3, v1
    s_lshl_b32 s32, s6, 8
    s_add_u32 s32, s32, s7
    s_lshl_b32 s32, s32, 7
    v_lshl_add_u32 v37, v38, 7, v15
    v_lshl_add_u32 v37, v37, 4, s32
    s_lshl_b32 s32, s6, 11
    s_lshr_b32 s33, s7, 2
    s_lshl_b32 s33, s33, 3
    s_add_u32 s32, s32, s33
    s_add_u32 s32, s32, 1048576
    v_lshl_add_u32 v38, v38, 7, s32
    v_lshrrev_b32 v14, 5, v1
    v_lshl_add_u32 v14, v14, 2, v15
    v_bfe_u32 v15, v1, 4, 1
    v_lshl_add_u32 v14, v14, 1, v15
    s_lshl_b32 s32, s34, 6
    v_lshl_add_u32 v14, v14, 2, s32
    s_mov_b32 s21, 0
    v_lshlrev_b32 v41, 31, v1
    v_or_b32 v41, 0x7ff, v41
    s_mov_b32 s22, 0x200000
    s_waitcnt lgkmcnt(0)
    s_mov_b64 exec, 1
    s_barrier
    s_waitcnt vmcnt(0)
    s_branch L_ctl_in
L_ctl:
    s_mov_b64 exec, 1
    s_barrier
L_ctl_in:
    s_add_u32 s32, s4, 0x10000
    v_lshl_or_b32 v7, v8, 8, s32
    global_store_dword v4, v7, s[16:17] offset:128
    s_bitcmp1_b32 s10, s21
    s_cbranch_scc1 L_rank0
    s_mov_b64 exec, -1
    global_load_dword v6, v5, s[16:17] offset:128 nt
    s_waitcnt vmcnt(2)
L_ranked0:
    v_cmp_le_i32 vcc, s4, v41
    v_readfirstlane_b32 s33, v41
    s_add_u32 s4, s4, 0x10000
    s_nop 0
    s_bcnt0_i32_b64 s32, vcc
    s_add_u32 s32, s32, s8
    s_bfe_u32 s33, s33, 0x50008
    s_sub_i32 s32, s32, s33
    s_ashr_i32 s32, s32, 3
    v_med3_i32 v2, s32, 0, 7
    ds_write_b32 v11, v2
    s_mov_b64 exec, 1
    s_barrier
    s_add_u32 s32, s4, 0x10000
    v_lshl_or_b32 v7, v8, 8, s32
    global_store_dword v4, v7, s[16:17] offset:128
    s_mov_b64 exec, -1
    global_load_dword v41, v5, s[16:17] offset:128 nt
    s_waitcnt vmcnt(2)
L_ranked1:
    v_cmp_le_i32 vcc, s4, v6
    v_readfirstlane_b32 s33, v6
    s_add_u32 s4, s4, 0x10000
    s_nop 0
    s_bcnt0_i32_b64 s32, vcc
    s_add_u32 s32, s32, s8
    s_bfe_u32 s33, s33, 0x50008
    s_sub_i32 s32, s32, s33
    s_ashr_i32 s32, s32, 3
    v_med3_i32 v2, s32, 0, 7
    ds_write_b32 v11, v2
    s_add_u32 s21, s21, 1
    s_cmp_lt_u32 s21, 31
    s_cbranch_scc1 L_ctl
    ds_read_b128 v[28:31], v13
    s_and_b32 s32, s4, 0xff
    v_xor_b32 v2, s32, v6
    v_and_b32 v3, 0xff, v2
    v_cmp_eq_u32 vcc, 0, v3
    s_lshr_b32 s32, s6, 3
    s_lshl_b32 s32, 0x55555555, s32
    s_and_b32 s33, s32, vcc_lo
    v_cmp_le_i32 vcc, 0x10000, v2
    s_nop 1
    s_and_b32 s33, s33, vcc_lo
    s_cmp_eq_u32 s32, s33
    s_cselect_b32 s9, 0, 0x80000000
    v_mov_b32 v2, s9
    ds_write_b32 v11, v2 offset:4
    s_waitcnt lgkmcnt(0)
    v_max3_f32 v16, v28, v29, v30
    v_max_f32 v16, v16, v31
    v_min_u32 v16, -2, v16
    s_barrier
    s_cbranch_scc0 L_notouch
    global_load_dword v7, v38, s[18:19] sc1
    global_load_dword v6, v37, s[18:19] sc1
L_notouch:
    s_barrier
    ds_read2_b32 v[28:29], v12 offset0:0 offset1:4
    s_waitcnt lgkmcnt(0)
    v_add_f32 v17, v28, v29
    s_nop 1
    v_add_f32_dpp v17, v17, v17 row_ror:8 row_mask:0xf bank_mask:0xf
    s_nop 1
    v_add_f32_dpp v17, v17, v17 row_ror:4 row_mask:0xf bank_mask:0xf
    s_nop 1
    v_add_f32_dpp v17, v17, v17 row_ror:2 row_mask:0xf bank_mask:0xf
    s_nop 1
    v_add_f32_dpp v17, v17, v17 row_ror:1 row_mask:0xf bank_mask:0xf
    v_or_b32 v17, s9, v17
    v_min_u32 v17, -2, v17
    s_mov_b32 exec_lo, 0x00010001
    s_mov_b32 exec_hi, 0x00010001
    global_store_dwordx2 v36, v[16:17], s[18:19]
    s_mov_b64 exec, -1
    s_barrier
    s_cbranch_scc0 L_slow
    global_load_dwordx2 v[18:19], v38, s[18:19] sc1
    s_barrier
    s_waitcnt vmcnt(0)
L_ml:
    v_max_u32 v2, v18, v19
    v_cmp_eq_u32 vcc, -1, v2
    s_nop 1
    s_and_b64 exec, exec, vcc
    s_cbranch_scc1 L_ml_again
    s_mov_b64 exec, -1
    global_load_dwordx4 v[20:23], v37, s[18:19] sc1
    global_load_dwordx4 v[24:27], v37, s[18:19] offset:64 sc1
    v_max_f32_dpp v2, v18, v18 row_ror:4 row_mask:0xf bank_mask:0xf
    v_cmp_gt_i32 s[10:11], 0, v19
    s_nop 0
    v_max_f32_dpp v2, v2, v2 row_ror:8 row_mask:0xf bank_mask:0xf
    v_mov_b32 v3, v2
    s_nop 1
    v_permlane16_swap_b32 v2, v3
    v_max_f32 v2, v2, v3
    v_mov_b32 v3, v2
    s_nop 1
    v_permlane32_swap_b32 v2, v3
    v_max_f32 v2, v2, v3
    v_sub_f32 v15, v18, v2
    v_mul_f32 v15, s23, v15
    v_exp_f32 v15, v15
    s_nop 0
    v_mul_f32 v2, v15, abs(v19)
    s_nop 1
    v_add_f32_dpp v2, v2, v2 row_ror:4 row_mask:0xf bank_mask:0xf
    s_nop 1
    v_add_f32_dpp v2, v2, v2 row_ror:8 row_mask:0xf bank_mask:0xf
    v_mov_b32 v3, v2
    global_load_dwordx4 v[20:23], v37, s[18:19] sc1
    global_load_dwordx4 v[24:27], v37, s[18:19] offset:64 sc1
    v_permlane16_swap_b32 v2, v3
    v_add_f32 v2, v2, v3
    v_mov_b32 v3, v2
    s_nop 1
    v_permlane32_swap_b32 v2, v3
    v_add_f32 v2, v2, v3
    v_rcp_f32 v2, v2
    s_nop 0
    v_mul_f32 v15, v15, v2
L_o:
    global_load_dwordx4 v[20:23], v37, s[18:19] sc1
    global_load_dwordx4 v[24:27], v37, s[18:19] offset:64 sc1
    s_sub_u32 s22, s22, 1
    s_cbranch_scc1 L_end
    s_waitcnt vmcnt(4)
    v_max3_u32 v2, v20, v21, v22
    v_max3_u32 v3, v23, v24, v25
    v_max3_u32 v2, v2, v26, v27
    v_max_u32 v2, v2, v3
    v_cmp_eq_u32 vcc, -1, v2
    s_nop 1
    s_and_b64 exec, exec, vcc
    s_cbranch_scc1 L_o
    s_mov_b64 exec, -1
    v_pk_mul_f32 v[28:29], v[20:21], v[14:15] op_sel:[0,1] op_sel_hi:[1,1]
    v_pk_mul_f32 v[30:31], v[22:23], v[14:15] op_sel:[0,1] op_sel_hi:[1,1]
    v_pk_mul_f32 v[32:33], v[24:25], v[14:15] op_sel:[0,1] op_sel_hi:[1,1]
    v_pk_mul_f32 v[34:35], v[26:27], v[14:15] op_sel:[0,1] op_sel_hi:[1,1]
    s_nop 0
    v_permlane32_swap_b32 v28, v32
    v_permlane32_swap_b32 v29, v33
    v_permlane32_swap_b32 v30, v34
    v_permlane32_swap_b32 v31, v35
    v_pk_add_f32 v[28:29], v[28:29], v[32:33]
    v_pk_add_f32 v[30:31], v[30:31], v[34:35]
    s_nop 1
    v_permlane16_swap_b32 v28, v30
    v_permlane16_swap_b32 v29, v31
    v_pk_add_f32 v[28:29], v[28:29], v[30:31]
    s_cmp_lg_u64 s[10:11], 0
    s_nop 0
    v_add_f32_dpp v28, v28, v28 row_ror:4 row_mask:0xf bank_mask:0xf
    v_add_f32_dpp v29, v29, v29 row_ror:4 row_mask:0xf bank_mask:0xf
    s_nop 0
    v_add_f32_dpp v28, v28, v28 row_ror:8 row_mask:0xf bank_mask:0xf
    v_add_f32_dpp v29, v29, v29 row_ror:8 row_mask:0xf bank_mask:0xf
    s_mov_b32 exec_lo, 0x000f000f
    s_mov_b32 exec_hi, 0x000f000f
    v_cvt_pk_bf16_f32 v28, v28, v29
    global_store_dword v14, v28, s[14:15]
    s_cbranch_scc1 L_help
L_fin:
    s_endpgm
L_rank0:
    global_atomic_add v8, v9, v10, s[16:17] sc0
    v_add_u32 v9, 4, v9
    s_mov_b64 exec, -1
    global_load_dword v6, v5, s[16:17] offset:128 nt
    s_waitcnt vmcnt(3)
    s_branch L_ranked0
L_help:
    s_cmp_lg_u32 s9, 0
    s_cbranch_scc1 L_fin
    s_waitcnt vmcnt(0)
    s_barrier
    s_mov_b64 exec, 1
    v_mov_b32 v7, 1
    global_atomic_add v39, v7, s[16:17]
    s_branch L_fin
L_slow:
    s_barrier
    s_mov_b32 exec_lo, 0x00010001
    s_mov_b32 exec_hi, 0x00010001
    global_store_dwordx2 v36, v[16:17], s[18:19] sc1
    s_mov_b64 exec, -1
    s_waitcnt vmcnt(0)
    s_barrier
    s_mov_b64 exec, 1
    v_mov_b32 v7, 1
    global_atomic_add v39, v7, s[16:17]
L_cnt:
    s_sub_u32 s22, s22, 1
    s_cbranch_scc1 L_end
    global_load_dword v6, v39, s[16:17] sc1
    s_waitcnt vmcnt(0)
    v_readfirstlane_b32 s32, v6
    s_nop 1
    s_cmp_ge_u32 s32, 16
    s_cbranch_scc0 L_cnt
    s_mov_b64 exec, -1
L_ml_again:
    global_load_dwordx2 v[18:19], v38, s[18:19] sc1
    s_sub_u32 s22, s22, 1
    s_cbranch_scc1 L_end
    s_waitcnt vmcnt(0)
    s_branch L_ml
L_cons:
    s_load_dwordx2 s[4:5], s[0:1], 0
    s_load_dwordx4 s[8:11], s[0:1], 24
    v_and_b32 v3, 63, v0
    s_lshr_b32 s3, s3, 6
    s_sub_u32 s3, s3, 1
    s_mov_b32 s23, 0x3e0293ee
    v_lshrrev_b32 v9, 4, v3
    v_lshlrev_b32 v9, 6, v9
    v_and_b32 v10, 3, v3
    v_bfe_u32 v7, v3, 2, 2
    v_lshl_add_u32 v8, v10, 4, v9
    v_lshl_add_u32 v2, v7, 8, v8
    v_lshl_add_u32 v9, v10, 8, v9
    v_lshl_add_u32 v9, v7, 4, v9
    v_lshlrev_b32 v4, 4, v3
    s_lshl_b32 s32, s6, 10
    s_lshl_b32 s33, s6, 8
    v_add_u32 v9, s32, v9
    v_add_u32 v8, s33, v8
    v_and_b32 v10, 0xf0, v4
    v_add_u32 v10, s33, v10
    v_mov_b32 v72, 0
    v_mov_b32 v73, 0
    v_mov_b32 v74, 0
    v_mov_b32 v75, 0
    s_or_b32 s36, s7, s3
    s_waitcnt lgkmcnt(0)
    global_load_dwordx4 v[16:19], v9, s[4:5]
    s_cbranch_scc1 L_notree
    global_load_dwordx4 v[56:59], v8, s[8:9]
    global_load_dwordx4 v[72:75], v10, s[10:11]
    s_load_dword s35, s[12:13], 0
L_notree:
    s_lshl_b32 s32, s3, 10
    v_and_b32 v9, 32, v3
    v_lshlrev_b32 v9, 2, v9
    v_xor_b32 v4, v4, v9
    v_add_u32 v4, s32, v4
    v_and_b32 v9, 8, v3
    v_lshlrev_b32 v9, 4, v9
    v_xor_b32 v2, v2, v9
    v_add_u32 v2, s32, v2
    s_lshl_b32 s32, s3, 8
    s_add_u32 s32, s32, 73728
    v_lshl_add_u32 v13, v3, 2, s32
    v_and_b32 v7, 3, v3
    v_lshlrev_b32 v7, 4, v7
    v_add_u32 v7, 74752, v7
    v_bfe_u32 v9, v3, 4, 1
    v_bfe_u32 v10, v3, 5, 1
    v_lshl_add_u32 v9, v9, 1, v10
    v_and_b32 v10, 15, v3
    v_lshl_add_u32 v9, v10, 2, v9
    s_lshl_b32 s32, s3, 11
    s_add_u32 s32, s32, 65536
    v_lshl_add_u32 v11, v9, 2, s32
    v_xor_b32 v12, 0x80, v11
    v_and_b32 v9, 8, v3
    v_lshlrev_b32 v9, 1, v9
    v_mov_b32 v10, 0xffff
    v_lshlrev_b32 v9, v9, v10
    v_bfe_i32 v10, v3, 2, 1
    v_and_b32 v6, v9, v10
    v_xor_b32 v5, v9, v6
    v_mov_b32 v14, 0xff800000
    v_mov_b32 v1, v14
    s_mov_b32 s21, 0
    s_cmp_lg_u32 s36, 0
    s_barrier
    s_waitcnt vmcnt(0) lgkmcnt(0)
    s_cbranch_scc1 L_k_in
    v_mfma_f32_16x16x32_bf16 v[40:43], v[56:59], v[16:19], 0
    s_lshr_b32 s32, s6, 3
    s_lshl_b32 s32, s32, 4
    s_lshr_b32 s35, s35, s32
    s_lshl_b32 s35, s35, 16
    v_mov_b32 v9, s35
    v_sub_f32 v9, 1.0, v9
    v_mul_f32 v9, 0xd028965f, v9
    s_nop 0
    v_add_f32_dpp v14, v41, v40 row_ror:12 row_mask:0xf bank_mask:0x1
    s_nop 1
    v_add_f32_dpp v14, v43, v42 row_ror:12 row_mask:0xf bank_mask:0x4
    s_nop 1
    v_add_f32_dpp v14, v40, v41 row_ror:4 row_mask:0xf bank_mask:0x2
    s_nop 1
    v_add_f32_dpp v14, v42, v43 row_ror:4 row_mask:0xf bank_mask:0x8
    s_nop 1
    v_add_f32_dpp v14, v14, v14 row_ror:8 row_mask:0xf bank_mask:0xf
    v_add_f32 v14, v14, v9
    s_mov_b64 exec, 0xffff
    v_mov_b32 v1, v14
    s_mov_b64 exec, -1
    s_branch L_k_in
L_k:
    s_barrier
L_k_in:
    ds_read_b128 v[56:59], v2 offset:0
    ds_read_b128 v[60:63], v2 offset:4096
    ds_read_b128 v[64:67], v2 offset:8192
    ds_read_b128 v[68:71], v2 offset:12288
    v_add_u32 v2, 16384, v2
    v_and_b32 v2, 65535, v2
    s_waitcnt lgkmcnt(3)
    v_mfma_f32_16x16x32_bf16 v[40:43], v[56:59], v[16:19], 0
    s_waitcnt lgkmcnt(2)
    v_mfma_f32_16x16x32_bf16 v[44:47], v[60:63], v[16:19], 0
    s_waitcnt lgkmcnt(1)
    v_mfma_f32_16x16x32_bf16 v[48:51], v[64:67], v[16:19], 0
    s_waitcnt lgkmcnt(0)
    v_mfma_f32_16x16x32_bf16 v[52:55], v[68:71], v[16:19], 0
    s_nop 1
    v_add_f32_dpp v28, v41, v40 row_ror:12 row_mask:0xf bank_mask:0x1
    s_nop 2
    v_add_f32_dpp v29, v49, v48 row_ror:12 row_mask:0xf bank_mask:0x1
    v_add_f32_dpp v28, v43, v42 row_ror:12 row_mask:0xf bank_mask:0x4
    s_nop 0
    v_add_f32_dpp v29, v51, v50 row_ror:12 row_mask:0xf bank_mask:0x4
    v_add_f32_dpp v28, v44, v45 row_ror:4 row_mask:0xf bank_mask:0x2
    s_nop 0
    v_add_f32_dpp v29, v52, v53 row_ror:4 row_mask:0xf bank_mask:0x2
    v_add_f32_dpp v28, v46, v47 row_ror:4 row_mask:0xf bank_mask:0x8
    s_nop 0
    v_add_f32_dpp v29, v54, v55 row_ror:4 row_mask:0xf bank_mask:0x8
    v_add_f32_dpp v28, v28, v28 row_ror:8 row_mask:0xf bank_mask:0xf
    s_nop 0
    v_add_f32_dpp v29, v29, v29 row_ror:8 row_mask:0xf bank_mask:0xf
    s_set_gpr_idx_on s21, gpr_idx(DST)
    v_mov_b32 v76, v28
    v_mov_b32 v77, v29
    s_set_gpr_idx_off
    v_max3_f32 v14, v14, v28, v29
    s_add_u32 s21, s21, 2
    s_cmp_lt_u32 s21, 64
    s_cbranch_scc1 L_k
    v_max_f32_dpp v14, v14, v14 row_ror:4 row_mask:0xf bank_mask:0xf
    v_mov_b32 v10, v14
    s_nop 1
    v_permlane16_swap_b32 v14, v10
    v_max_f32 v14, v14, v10
    v_mov_b32 v10, v14
    s_nop 1
    v_permlane32_swap_b32 v14, v10
    v_max_f32 v14, v14, v10
    v_lshl_add_u32 v9, s3, 2, v7
    ds_write_b32 v9, v14
    s_mov_b32 s21, 0
    s_waitcnt lgkmcnt(0)
    s_barrier
    ds_read_b128 v[40:43], v7
    s_waitcnt lgkmcnt(0)
    v_max3_f32 v14, v40, v41, v42
    v_max_f32 v14, v14, v43
    v_mul_f32 v8, 0xbe0293ee, v14
    v_fma_f32 v9, v1, s23, v8
    v_exp_f32 v9, v9
    v_cmp_ne_u32 vcc, 0, v5
    v_cvt_pk_bf16_f32 v10, v9, v9
    v_and_b32 v30, v10, v5
    v_and_b32 v31, v10, v6
    v_cndmask_b32 v15, 0, v9, vcc
    s_nop 0
    v_mfma_f32_16x16x16_bf16 v[20:23], v[30:31], v[72:73], 0
    v_mfma_f32_16x16x16_bf16 v[24:27], v[30:31], v[74:75], 0
    s_set_gpr_idx_on s21, gpr_idx(SRC0)
    v_mov_b32 v28, v76
    v_mov_b32 v29, v77
    s_set_gpr_idx_off
    v_fma_f32 v28, v28, s23, v8
    v_fma_f32 v29, v29, s23, v8
    v_exp_f32 v28, v28
    v_exp_f32 v29, v29
    s_add_u32 s21, s21, 2
    s_cmp_lt_u32 s21, 62
    v_add_f32 v15, v15, v28
    v_add_f32 v15, v15, v29
    v_cvt_pk_bf16_f32 v28, v28, v28
    v_cvt_pk_bf16_f32 v29, v29, v29
    v_and_b32 v30, v28, v5
    v_and_b32 v33, v28, v6
    v_and_b32_dpp v31, v28, v6 row_ror:4 row_mask:0xf bank_mask:0xf
    v_and_b32_dpp v32, v28, v5 row_ror:4 row_mask:0xf bank_mask:0xf
    v_and_b32 v34, v29, v5
    v_and_b32 v37, v29, v6
    v_and_b32_dpp v35, v29, v6 row_ror:4 row_mask:0xf bank_mask:0xf
    v_and_b32_dpp v36, v29, v5 row_ror:4 row_mask:0xf bank_mask:0xf
    s_branch L_v_in
L_v:
    s_set_gpr_idx_on s21, gpr_idx(SRC0)
    v_mov_b32 v28, v76
    v_mov_b32 v29, v77
    s_set_gpr_idx_off
    v_fma_f32 v28, v28, s23, v8
    v_fma_f32 v29, v29, s23, v8
    v_exp_f32 v28, v28
    v_exp_f32 v29, v29
    s_add_u32 s21, s21, 2
    s_cmp_lt_u32 s21, 62
    v_add_f32 v15, v15, v28
    v_add_f32 v15, v15, v29
    v_cvt_pk_bf16_f32 v28, v28, v28
    v_cvt_pk_bf16_f32 v29, v29, v29
    v_and_b32 v30, v28, v5
    v_and_b32 v33, v28, v6
    v_and_b32_dpp v31, v28, v6 row_ror:4 row_mask:0xf bank_mask:0xf
    v_and_b32_dpp v32, v28, v5 row_ror:4 row_mask:0xf bank_mask:0xf
    v_and_b32 v34, v29, v5
    v_and_b32 v37, v29, v6
    v_and_b32_dpp v35, v29, v6 row_ror:4 row_mask:0xf bank_mask:0xf
    v_and_b32_dpp v36, v29, v5 row_ror:4 row_mask:0xf bank_mask:0xf
    s_barrier
L_v_in:
    ds_read_b128 v[56:59], v4 offset:0
    ds_read_b128 v[60:63], v4 offset:4096
    ds_read_b128 v[64:67], v4 offset:8192
    ds_read_b128 v[68:71], v4 offset:12288
    v_add_u32 v4, 16384, v4
    v_and_b32 v4, 65535, v4
    s_waitcnt lgkmcnt(3)
    v_mfma_f32_16x16x16_bf16 v[20:23], v[30:31], v[56:57], v[20:23]
    v_mfma_f32_16x16x16_bf16 v[24:27], v[30:31], v[58:59], v[24:27]
    s_waitcnt lgkmcnt(2)
    v_mfma_f32_16x16x16_bf16 v[20:23], v[32:33], v[60:61], v[20:23]
    v_mfma_f32_16x16x16_bf16 v[24:27], v[32:33], v[62:63], v[24:27]
    s_waitcnt lgkmcnt(1)
    v_mfma_f32_16x16x16_bf16 v[20:23], v[34:35], v[64:65], v[20:23]
    v_mfma_f32_16x16x16_bf16 v[24:27], v[34:35], v[66:67], v[24:27]
    s_waitcnt lgkmcnt(0)
    v_mfma_f32_16x16x16_bf16 v[20:23], v[36:37], v[68:69], v[20:23]
    v_mfma_f32_16x16x16_bf16 v[24:27], v[36:37], v[70:71], v[24:27]
    s_cbranch_scc1 L_v
    s_set_gpr_idx_on s21, gpr_idx(SRC0)
    v_mov_b32 v28, v76
    v_mov_b32 v29, v77
    s_set_gpr_idx_off
    v_fma_f32 v28, v28, s23, v8
    v_fma_f32 v29, v29, s23, v8
    v_exp_f32 v28, v28
    v_exp_f32 v29, v29
    s_add_u32 s21, s21, 2
    s_cmp_lt_u32 s21, 62
    v_add_f32 v15, v15, v28
    v_add_f32 v15, v15, v29
    v_cvt_pk_bf16_f32 v28, v28, v28
    v_cvt_pk_bf16_f32 v29, v29, v29
    v_and_b32 v30, v28, v5
    v_and_b32 v33, v28, v6
    v_and_b32_dpp v31, v28, v6 row_ror:4 row_mask:0xf bank_mask:0xf
    v_and_b32_dpp v32, v28, v5 row_ror:4 row_mask:0xf bank_mask:0xf
    v_and_b32 v34, v29, v5
    v_and_b32 v37, v29, v6
    v_and_b32_dpp v35, v29, v6 row_ror:4 row_mask:0xf bank_mask:0xf
    v_and_b32_dpp v36, v29, v5 row_ror:4 row_mask:0xf bank_mask:0xf
    ds_write_b32 v13, v15
    s_waitcnt lgkmcnt(0)
    s_barrier
    ds_read_b128 v[56:59], v4 offset:0
    ds_read_b128 v[60:63], v4 offset:4096
    ds_read_b128 v[64:67], v4 offset:8192
    s_waitcnt lgkmcnt(2)
    v_mfma_f32_16x16x16_bf16 v[20:23], v[30:31], v[56:57], v[20:23]
    v_mfma_f32_16x16x16_bf16 v[24:27], v[30:31], v[58:59], v[24:27]
    s_waitcnt lgkmcnt(1)
    v_mfma_f32_16x16x16_bf16 v[20:23], v[32:33], v[60:61], v[20:23]
    v_mfma_f32_16x16x16_bf16 v[24:27], v[32:33], v[62:63], v[24:27]
    s_waitcnt lgkmcnt(0)
    v_mfma_f32_16x16x16_bf16 v[20:23], v[34:35], v[64:65], v[20:23]
    v_mfma_f32_16x16x16_bf16 v[24:27], v[34:35], v[66:67], v[24:27]
    s_barrier
    ds_read_b128 v[68:71], v4 offset:12288
    s_waitcnt lgkmcnt(0)
    v_mfma_f32_16x16x16_bf16 v[20:23], v[36:37], v[68:69], v[20:23]
    v_mfma_f32_16x16x16_bf16 v[24:27], v[36:37], v[70:71], v[24:27]
    s_nop 6
    ds_write_b32 v11, v20 offset:0
    ds_write_b32 v11, v21 offset:512
    ds_write_b32 v11, v22 offset:1024
    ds_write_b32 v11, v23 offset:1536
    ds_write_b32 v12, v24 offset:256
    ds_write_b32 v12, v25 offset:768
    ds_write_b32 v12, v26 offset:1280
    ds_write_b32 v12, v27 offset:1792
    s_waitcnt lgkmcnt(0)
    s_barrier
L_last:
    s_endpgm
.section .rodata,"a"
.p2align 6
.amdhsa_kernel standalone__tree_speculative_verify_tree_attention_over_candidate_token_tree__decode_kernel
  .amdhsa_next_free_vgpr 140
  .amdhsa_next_free_sgpr 64
  .amdhsa_accum_offset 140
  .amdhsa_group_segment_fixed_size 0
  .amdhsa_kernarg_size 72
  .amdhsa_user_sgpr_count 2
  .amdhsa_user_sgpr_kernarg_segment_ptr 1
  .amdhsa_system_sgpr_workgroup_id_x 1
.end_amdhsa_kernel
```
